```python
import torch

def _softmax(x, axis=-1):
    return torch.softmax(x, dim=axis)
def _gelu(x):
    return torch.nn.functional.gelu(x, approximate="tanh")
def _silu(x):
    return torch.nn.functional.silu(x)
def _sigmoid(x):
    return torch.sigmoid(x)
def _layernorm(x, axis=-1, eps=1e-5):
    m = x.mean(dim=axis, keepdim=True)
    v = x.var(dim=axis, keepdim=True, unbiased=False)
    return (x - m) / torch.sqrt(v + eps)
def _scatter_add(tgt, idx, src, axis=0):
    return tgt.clone().index_add_(axis, idx, src)
def _segment_sum(src, seg, n):
    out = torch.zeros((n,) + src.shape[1:], dtype=src.dtype)
    return out.index_add_(0, seg, src)
def _pad(x, pw):
    flat = tuple(v for pair in reversed(pw) for v in pair)
    return torch.nn.functional.pad(x, flat)

kernel_name = 'standalone__depthwise_separable__vision'

def setup_inputs():

    _w = (lambda a: (lambda t: t.to(torch.bfloat16) if t.is_floating_point() else t)(torch.as_tensor(a)))
    H = W = 384
    C = 96
    k = 3
    return {
        "x": _w((lambda *s: torch.randn(*s, dtype=torch.bfloat16) * 0.05)(1, H, W, C)),
        "dw": _w((lambda *s: torch.randn(*s, dtype=torch.bfloat16) * 0.05)(k, k, C)),
        "pw": _w((lambda *s: torch.randn(*s, dtype=torch.bfloat16) * 0.05)(C, C)),
    }

def reference(x, dw, pw):
    B, H, W, C = x.shape
    k = dw.shape[0]
    pad = k // 2
    xp = _pad(x, ((0,0),(pad,pad),(pad,pad),(0,0)))
    out = torch.zeros_like(x)
    for i in range(k):
        for j in range(k):
            out = out + xp[:, i:i+H, j:j+W, :] * dw[i, j][None, None, None, :]
    return torch.einsum('bhwc,cd->bhwd', out, pw)
```

```asm
; @launch grid=(256,1,1) block=(256,1,1) lds=158464
.amdgcn_target "amdgcn-amd-amdhsa--gfx950"
.text
.globl standalone__depthwise_separable__vision_kernel
.p2align 12
.skip 0xd00
.p2align 8
.type standalone__depthwise_separable__vision_kernel,@function
standalone__depthwise_separable__vision_kernel:
    s_load_dwordx4 s[4:7], s[0:1], 0
    s_load_dwordx4 s[8:11], s[0:1], 16
    s_cmp_ge_u32 s2, 256
    s_cbranch_scc1 L_end
    v_readfirstlane_b32 s12, v0
    s_and_b32 s13, s2, 7
    s_bfe_u32 s15, s2, 0x10003
    s_lshr_b32 s14, s2, 4
    s_lshl1_add_u32 s15, s13, s15
    s_mul_i32 s16, s15, 1769472
    s_mul_i32 s17, s14, 4608
    s_add_u32 s16, s16, s17
    s_mov_b32 s46, 73728
    s_bitcmp1_b32 s15, 0
    s_cselect_b32 s46, -73728, s46
    s_cselect_b32 s17, 1843200, 0
    s_mov_b32 s27, 0x20000
    s_lshr_b32 s12, s12, 6
    s_cbranch_scc1 L_prep
    s_mov_b32 s23, s27
    s_ashr_i32 s47, s46, 31
    s_add_u32 s17, s17, s16
    s_sub_u32 s17, s17, 73984
    s_ashr_i32 s29, s17, 31
    v_lshlrev_b32 v33, 4, v0
    s_cmp_eq_u32 s14, 0
    s_cselect_b32 s18, 16, 4
    v_bfrev_b32 v35, 2
    v_cmp_gt_u32 vcc, s18, v0
    s_cmp_eq_u32 s14, 15
    s_cselect_b32 s19, 48, 60
    v_cndmask_b32 v32, v33, v35, vcc
    v_cmp_le_u32 vcc, s19, v0
    v_add_u32 v34, 0x1000, v33
    s_add_u32 s18, s15, 1
    s_and_b32 s18, s18, 14
    s_cselect_b32 s22, 5120, 0
    v_cndmask_b32 v34, v34, v35, vcc
    s_mov_b32 s33, 0
    s_mov_b32 m0, 0
    s_mov_b32 s28, 0
    s_mov_b32 s13, 0
    s_movk_i32 s26, 18432
    s_mov_b32 s31, 0x48000
    s_waitcnt lgkmcnt(0)
    s_add_u32 s20, s4, s17
    s_addc_u32 s21, s5, s29
L_rowa:
    buffer_load_dwordx4 v32, s[20:23], 0 offen offset:0 lds
    buffer_load_dwordx4 v33, s[20:23], 0 offen offset:1024 lds
    buffer_load_dwordx4 v33, s[20:23], 0 offen offset:2048 lds
    buffer_load_dwordx4 v33, s[20:23], 0 offen offset:3072 lds
    s_add_u32 m0, s33, 4096
    s_and_b32 s30, s28, 1
    buffer_load_dwordx4 v34, s[20:23], 0 offen lds
    s_lshl4_add_u32 s33, s30, s33
    s_addk_i32 s33, 5120
    s_mov_b32 m0, s33
    s_add_u32 s20, s20, s46
    s_addc_u32 s21, s21, s47
    s_movk_i32 s22, 5120
    s_mov_b64 s[24:25], s[8:9]
    s_add_u32 s28, s28, 1
    s_cmp_lt_u32 s28, 2
    s_cbranch_scc1 L_rowa
L_rowb:
    s_add_u32 m0, s13, 133376
    s_nop 0
    buffer_load_dwordx4 v33, s[24:27], s13 offen offset:0 lds
    buffer_load_dwordx4 v33, s[24:27], s13 offen offset:1024 lds
    buffer_load_dwordx4 v33, s[24:27], s13 offen offset:2048 lds
    s_mov_b32 m0, s33
    s_addk_i32 s13, 3072
    buffer_load_dwordx4 v32, s[20:23], 0 offen offset:0 nt lds
    buffer_load_dwordx4 v33, s[20:23], 0 offen offset:1024 nt lds
    buffer_load_dwordx4 v33, s[20:23], 0 offen offset:2048 nt lds
    buffer_load_dwordx4 v33, s[20:23], 0 offen offset:3072 nt lds
    s_add_u32 m0, s33, 4096
    s_and_b32 s30, s28, 1
    buffer_load_dwordx4 v34, s[20:23], 0 offen nt lds
    s_lshl4_add_u32 s33, s30, s33
    s_addk_i32 s33, 5120
    s_mov_b32 m0, s33
    s_add_u32 s20, s20, s46
    s_addc_u32 s21, s21, s47
    s_add_u32 s28, s28, 1
    s_waitcnt vmcnt(55)
    s_cmp_lt_u32 s28, 8
    s_cbranch_scc1 L_rowb
L_rowc:
    buffer_load_dwordx4 v32, s[20:23], 0 offen offset:0 nt lds
    buffer_load_dwordx4 v33, s[20:23], 0 offen offset:1024 nt lds
    buffer_load_dwordx4 v33, s[20:23], 0 offen offset:2048 nt lds
    buffer_load_dwordx4 v33, s[20:23], 0 offen offset:3072 nt lds
    s_add_u32 m0, s33, 4096
    s_and_b32 s30, s28, 1
    buffer_load_dwordx4 v34, s[20:23], 0 offen nt lds
    s_lshl4_add_u32 s33, s30, s33
    s_addk_i32 s33, 5120
    s_mov_b32 m0, s33
    s_add_u32 s20, s20, s46
    s_addc_u32 s21, s21, s47
    s_add_u32 s28, s28, 1
    s_waitcnt vmcnt(55)
    s_bitcmp0_b32 s31, s28
    s_cbranch_scc1 L_nobar
    s_waitcnt vmcnt(40)
    s_barrier
L_nobar:
    s_cmp_lt_u32 s28, 24
    s_cbranch_scc1 L_rowc
L_rowd:
    buffer_load_dwordx4 v32, s[20:23], 0 offen offset:0 lds
    buffer_load_dwordx4 v33, s[20:23], 0 offen offset:1024 lds
    buffer_load_dwordx4 v33, s[20:23], 0 offen offset:2048 lds
    buffer_load_dwordx4 v33, s[20:23], 0 offen offset:3072 lds
    s_add_u32 m0, s33, 4096
    s_and_b32 s30, s28, 1
    buffer_load_dwordx4 v34, s[20:23], 0 offen lds
    s_lshl4_add_u32 s33, s30, s33
    s_addk_i32 s33, 5120
    s_mov_b32 m0, s33
    s_add_u32 s20, s20, s46
    s_addc_u32 s21, s21, s47
    s_add_u32 s28, s28, 1
    s_waitcnt vmcnt(55)
    s_cmp_lt_u32 s28, 26
    s_cbranch_scc1 L_rowd
    s_waitcnt vmcnt(0)
    s_barrier
    s_endpgm
L_prep:
    s_mov_b64 exec, 0
    s_cmp_eq_u32 s12, 1
    s_cbranch_scc1 L_pad0
    s_cmp_eq_u32 s12, 2
    s_cbranch_scc1 L_pad1
    s_branch L_pad2
L_back:
    s_mov_b64 exec, -1
    v_and_b32 v0, 63, v0
    s_sub_u32 s12, s12, 1
    v_lshlrev_b32 v41, 4, v0
    s_lshl_b32 s13, s12, 11
    s_add_u32 s18, s13, 151808
    s_mov_b32 m0, s18
    s_movk_i32 s26, 1728
    s_waitcnt lgkmcnt(0)
    s_mov_b64 s[24:25], s[6:7]
    buffer_load_dwordx4 v41, s[24:27], 0 offen lds
    buffer_load_dwordx4 v41, s[24:27], 0 offen offset:1024 lds
    v_lshrrev_b32 v37, 4, v0
    v_bfe_u32 v40, v0, 1, 1
    v_sub_u32 v38, v37, v40
    v_and_b32 v42, 1, v37
    v_lshlrev_b32 v42, 1, v42
    v_sub_u32 v42, v42, v40
    v_cmp_gt_u32 vcc, 3, v38
    v_cmp_le_i32 s[56:57], 0, v42
    v_cmp_gt_i32 s[58:59], 2, v42
    s_bitcmp1_b32 s15, 0
    s_cselect_b32 s19, 1152, 0
    s_cselect_b32 s17, 1179648, 0
    s_cselect_b32 s34, 516096, 0
    s_add_u32 s18, s18, s19
    s_ashr_i32 s19, s46, 7
    v_and_b32 v39, 12, v0
    v_add_u32 v43, s18, v39
    v_mad_i32_i24 v38, s19, v38, v43
    v_mad_i32_i24 v42, s19, v42, v43
    v_lshrrev_b32 v43, 5, v0
    v_mul_u32_u24 v43, 192, v43
    v_add_u32 v42, v42, v43
    v_add_u32 v43, s19, v42
    v_and_b32 v40, 1, v0
    v_lshlrev_b32 v40, 4, v40
    v_mov_b32 v36, 0xffff
    v_lshlrev_b32 v40, v40, v36
    v_cndmask_b32 v52, 0, v40, vcc
    v_cndmask_b32 v53, 0, v40, s[56:57]
    v_cndmask_b32 v54, 0, v40, s[58:59]
    v_cmp_eq_u32 s[50:51], 0, v39
    v_cmp_eq_u32 s[52:53], 4, v39
    v_cmp_eq_u32 s[54:55], 8, v39
    v_cmp_eq_u32 s[56:57], 12, v39
    v_cmp_gt_u32 vcc, 8, v39
    v_add_u32 v41, 133376, v41
    v_bfe_u32 v40, v0, 2, 1
    v_cndmask_b32 v44, 0, v52, s[50:51]
    v_cndmask_b32 v45, 0, v52, s[52:53]
    v_cndmask_b32 v46, 0, v52, s[54:55]
    v_cndmask_b32 v47, 0, v52, s[56:57]
    v_cndmask_b32 v48, 0, v53, vcc
    v_cndmask_b32 v50, 0, v54, vcc
    v_xor_b32 v49, v48, v53
    v_xor_b32 v51, v50, v54
    v_mul_u32_u24 v40, 0xaaaa, v40
    v_add_u32 v232, 0x4444, v40
    v_and_b32 v36, 3, v0
    v_lshl_add_u32 v36, v36, 1, v37
    v_lshrrev_b32 v40, 1, v36
    v_mul_u32_u24 v36, 5120, v36
    v_lshl_add_u32 v36, v40, 4, v36
    v_mul_u32_u24 v39, 48, v39
    s_mul_i32 s30, s12, 768
    s_add_u32 s29, s30, 64
    v_add3_u32 v3, v36, v39, s29
    v_add_u32 v19, 41024, v3
    s_add_u32 s16, s16, s17
    s_add_u32 s16, s16, s30
    s_add_u32 s35, s34, s46
    s_add_u32 s36, s35, s46
    s_add_u32 s37, s36, s46
    s_add_u32 s38, s37, s46
    s_add_u32 s39, s38, s46
    s_add_u32 s40, s39, s46
    s_add_u32 s41, s40, s46
    v_mul_u32_u24 v36, 12, v0
    v_add_u32 v15, s16, v36
    v_mov_b32 v7, v15
    s_lshl_b32 s45, s46, 3
    s_movk_i32 s48, 2304
    s_movk_i32 s49, 2304
    s_movk_i32 s33, 1536
    s_mov_b32 s42, 0
    s_mov_b32 s43, 0
    s_mov_b32 s44, 3
    s_mov_b64 vcc, 0
    s_waitcnt vmcnt(0)
    s_mov_b64 s[24:25], s[10:11]
    s_mov_b32 s26, 28311552
    ds_read2_b32 v[64:65], v38 offset0:0 offset1:4
    ds_read2_b32 v[66:67], v38 offset0:8 offset1:12
    ds_read2_b32 v[68:69], v38 offset0:16 offset1:20
    ds_read2_b32 v[70:71], v38 offset0:24 offset1:28
    ds_read2_b32 v[72:73], v38 offset0:32 offset1:36
    ds_read2_b32 v[74:75], v38 offset0:40 offset1:44
    ds_read2_b32 v[76:77], v42 offset0:48 offset1:52
    ds_read2_b32 v[78:79], v42 offset0:56 offset1:60
    ds_read2_b32 v[80:81], v42 offset0:64 offset1:68
    ds_read2_b32 v[82:83], v42 offset0:72 offset1:76
    ds_read2_b32 v[84:85], v42 offset0:80 offset1:84
    ds_read2_b32 v[86:87], v42 offset0:88 offset1:92
    ds_read2_b32 v[88:89], v43 offset0:48 offset1:52
    ds_read2_b32 v[90:91], v43 offset0:56 offset1:60
    ds_read2_b32 v[92:93], v43 offset0:64 offset1:68
    ds_read2_b32 v[94:95], v43 offset0:72 offset1:76
    ds_read2_b32 v[96:97], v43 offset0:80 offset1:84
    ds_read2_b32 v[98:99], v43 offset0:88 offset1:92
    s_mul_i32 s19, s13, 3
    v_mul_u32_u24 v37, 192, v37
    v_add3_u32 v36, v36, v37, s19
    v_add_u32 v36, 133376, v36
    v_add_u32 v37, s19, v41
    s_mov_b32 s18, 0x05040100
    s_mov_b32 s19, 0x07060302
    s_waitcnt lgkmcnt(0)
    v_and_b32 v112, v44, v64
    v_and_b32 v113, v45, v64
    v_and_b32 v114, v46, v64
    v_and_b32 v115, v47, v64
    v_and_b32 v116, v48, v76
    v_and_b32 v117, v49, v76
    v_and_b32 v118, v50, v88
    v_and_b32 v119, v51, v88
    v_and_b32 v120, v44, v65
    v_and_b32 v121, v45, v65
    v_and_b32 v122, v46, v65
    v_and_b32 v123, v47, v65
    v_and_b32 v124, v48, v77
    v_and_b32 v125, v49, v77
    v_and_b32 v126, v50, v89
    v_and_b32 v127, v51, v89
    v_and_b32 v128, v44, v66
    v_and_b32 v129, v45, v66
    v_and_b32 v130, v46, v66
    v_and_b32 v131, v47, v66
    v_and_b32 v132, v48, v78
    v_and_b32 v133, v49, v78
    v_and_b32 v134, v50, v90
    v_and_b32 v135, v51, v90
    v_and_b32 v136, v44, v67
    v_and_b32 v137, v45, v67
    v_and_b32 v138, v46, v67
    v_and_b32 v139, v47, v67
    v_and_b32 v140, v48, v79
    v_and_b32 v141, v49, v79
    v_and_b32 v142, v50, v91
    v_and_b32 v143, v51, v91
    v_and_b32 v144, v44, v68
    v_and_b32 v145, v45, v68
    v_and_b32 v146, v46, v68
    v_and_b32 v147, v47, v68
    v_and_b32 v148, v48, v80
    v_and_b32 v149, v49, v80
    v_and_b32 v150, v50, v92
    v_and_b32 v151, v51, v92
    v_and_b32 v152, v44, v69
    v_and_b32 v153, v45, v69
    v_and_b32 v154, v46, v69
    v_and_b32 v155, v47, v69
    v_and_b32 v156, v48, v81
    v_and_b32 v157, v49, v81
    v_and_b32 v158, v50, v93
    v_and_b32 v159, v51, v93
    v_and_b32 v160, v44, v70
    v_and_b32 v161, v45, v70
    v_and_b32 v162, v46, v70
    v_and_b32 v163, v47, v70
    v_and_b32 v164, v48, v82
    v_and_b32 v165, v49, v82
    v_and_b32 v166, v50, v94
    v_and_b32 v167, v51, v94
    v_and_b32 v168, v44, v71
    v_and_b32 v169, v45, v71
    v_and_b32 v170, v46, v71
    v_and_b32 v171, v47, v71
    v_and_b32 v172, v48, v83
    v_and_b32 v173, v49, v83
    v_and_b32 v174, v50, v95
    v_and_b32 v175, v51, v95
    v_and_b32 v176, v44, v72
    v_and_b32 v177, v45, v72
    v_and_b32 v178, v46, v72
    v_and_b32 v179, v47, v72
    v_and_b32 v180, v48, v84
    v_and_b32 v181, v49, v84
    v_and_b32 v182, v50, v96
    v_and_b32 v183, v51, v96
    v_and_b32 v184, v44, v73
    v_and_b32 v185, v45, v73
    v_and_b32 v186, v46, v73
    v_and_b32 v187, v47, v73
    v_and_b32 v188, v48, v85
    v_and_b32 v189, v49, v85
    v_and_b32 v190, v50, v97
    v_and_b32 v191, v51, v97
    v_and_b32 v192, v44, v74
    v_and_b32 v193, v45, v74
    v_and_b32 v194, v46, v74
    v_and_b32 v195, v47, v74
    v_and_b32 v196, v48, v86
    v_and_b32 v197, v49, v86
    v_and_b32 v198, v50, v98
    v_and_b32 v199, v51, v98
    v_and_b32 v200, v44, v75
    v_and_b32 v201, v45, v75
    v_and_b32 v202, v46, v75
    v_and_b32 v203, v47, v75
    v_and_b32 v204, v48, v87
    v_and_b32 v205, v49, v87
    v_and_b32 v206, v50, v99
    v_and_b32 v207, v51, v99
    s_barrier
    ds_read2_b32 v[64:65], v36 offset0:0 offset1:48
    ds_read2_b32 v[66:67], v36 offset0:1 offset1:49
    ds_read2_b32 v[68:69], v36 offset0:2 offset1:50
    v_add_u32 v36, s33, v36
    ds_read2_b32 v[70:71], v36 offset0:0 offset1:48
    ds_read2_b32 v[72:73], v36 offset0:1 offset1:49
    ds_read2_b32 v[74:75], v36 offset0:2 offset1:50
    v_add_u32 v36, s33, v36
    ds_read2_b32 v[76:77], v36 offset0:0 offset1:48
    ds_read2_b32 v[78:79], v36 offset0:1 offset1:49
    ds_read2_b32 v[80:81], v36 offset0:2 offset1:50
    v_add_u32 v36, s33, v36
    ds_read2_b32 v[82:83], v36 offset0:0 offset1:48
    ds_read2_b32 v[84:85], v36 offset0:1 offset1:49
    ds_read2_b32 v[86:87], v36 offset0:2 offset1:50
    s_waitcnt lgkmcnt(9)
    v_perm_b32 v88, v65, v64, s18
    v_perm_b32 v92, v65, v64, s19
    v_perm_b32 v96, v67, v66, s18
    v_perm_b32 v100, v67, v66, s19
    v_perm_b32 v104, v69, v68, s18
    v_perm_b32 v108, v69, v68, s19
    s_waitcnt lgkmcnt(6)
    v_perm_b32 v89, v71, v70, s18
    v_perm_b32 v93, v71, v70, s19
    v_perm_b32 v97, v73, v72, s18
    v_perm_b32 v101, v73, v72, s19
    v_perm_b32 v105, v75, v74, s18
    v_perm_b32 v109, v75, v74, s19
    s_waitcnt lgkmcnt(3)
    v_perm_b32 v90, v77, v76, s18
    v_perm_b32 v94, v77, v76, s19
    v_perm_b32 v98, v79, v78, s18
    v_perm_b32 v102, v79, v78, s19
    v_perm_b32 v106, v81, v80, s18
    v_perm_b32 v110, v81, v80, s19
L_pad0:
    s_cbranch_execz L_back
    s_waitcnt lgkmcnt(0)
    v_perm_b32 v91, v83, v82, s18
    v_perm_b32 v95, v83, v82, s19
    v_perm_b32 v99, v85, v84, s18
    v_perm_b32 v103, v85, v84, s19
    v_perm_b32 v107, v87, v86, s18
    v_perm_b32 v111, v87, v86, s19
    ds_write_b128 v37, v[88:91] offset:0
    ds_write_b128 v37, v[92:95] offset:1024
    ds_write_b128 v37, v[96:99] offset:2048
    ds_write_b128 v37, v[100:103] offset:3072
    ds_write_b128 v37, v[104:107] offset:4096
    ds_write_b128 v37, v[108:111] offset:5120
    s_waitcnt lgkmcnt(0)
    s_barrier
    ds_read_b128 a[144:147], v41 offset:0
    ds_read_b128 a[148:151], v41 offset:1024
    ds_read_b128 a[152:155], v41 offset:2048
    ds_read_b128 a[156:159], v41 offset:3072
    ds_read_b128 a[160:163], v41 offset:4096
    ds_read_b128 a[164:167], v41 offset:5120
    ds_read_b128 a[168:171], v41 offset:6144
    ds_read_b128 a[172:175], v41 offset:7168
    ds_read_b128 a[176:179], v41 offset:8192
    ds_read_b128 a[180:183], v41 offset:9216
    ds_read_b128 a[184:187], v41 offset:10240
    ds_read_b128 a[188:191], v41 offset:11264
    ds_read_b128 a[192:195], v41 offset:12288
    ds_read_b128 a[196:199], v41 offset:13312
    ds_read_b128 a[200:203], v41 offset:14336
    ds_read_b128 a[204:207], v41 offset:15360
    ds_read_b128 a[208:211], v41 offset:16384
    ds_read_b128 a[212:215], v41 offset:17408
    s_cmp_lt_u32 s12, 2
    s_cbranch_scc1 L_first
    v_mov_b32 v3, v19
    s_mov_b32 s42, s45
    s_mov_b32 s33, s48
    s_sub_u32 s48, 41024, s48
    s_sub_u32 s49, s45, s49
    s_mov_b32 s43, 3
    s_mov_b32 s44, 2
    s_barrier
L_first:
    ds_read_b128 a[0:3], v3 offset:0
    ds_read_b128 a[4:7], v3 offset:192
    ds_read_b128 a[8:11], v3 offset:384
    ds_read_b128 a[12:15], v3 offset:16
    ds_read_b128 a[16:19], v3 offset:208
    ds_read_b128 a[20:23], v3 offset:400
    ds_read_b128 a[24:27], v3 offset:32
    ds_read_b128 a[28:31], v3 offset:224
    ds_read_b128 a[32:35], v3 offset:416
    ds_read_b128 a[36:39], v3 offset:48
    ds_read_b128 a[40:43], v3 offset:240
    ds_read_b128 a[44:47], v3 offset:432
    s_branch L_mid
L_loop:
    v_mfma_f32_16x16x32_bf16 v[88:91], v[220:223], a[168:171], v[88:91]
    ds_read_b128 a[0:3], v3 offset:0
    v_cvt_pk_bf16_f32 v0, v64, v68
    v_mfma_f32_16x16x32_bf16 v[92:95], v[220:223], a[172:175], v[92:95]
    ds_read_b128 a[4:7], v3 offset:192
    v_cvt_pk_bf16_f32 v4, v65, v69
    v_mfma_f32_16x16x32_bf16 v[96:99], v[220:223], a[176:179], v[96:99]
    ds_read_b128 a[8:11], v3 offset:384
    v_cvt_pk_bf16_f32 v8, v66, v70
    v_mfma_f32_16x16x32_bf16 v[100:103], v[220:223], a[180:183], v[100:103]
    ds_read_b128 a[12:15], v3 offset:16
    v_cvt_pk_bf16_f32 v12, v67, v71
    v_mfma_f32_16x16x32_bf16 v[104:107], v[220:223], a[184:187], v[104:107]
    ds_read_b128 a[16:19], v3 offset:208
    v_cvt_pk_bf16_f32 v1, v72, v76
    v_mfma_f32_16x16x32_bf16 v[108:111], v[220:223], a[188:191], v[108:111]
    ds_read_b128 a[20:23], v3 offset:400
    v_cvt_pk_bf16_f32 v5, v73, v77
    v_mfma_f32_16x16x32_bf16 v[88:91], v[228:231], a[192:195], v[88:91]
    ds_read_b128 a[24:27], v3 offset:32
    v_cvt_pk_bf16_f32 v9, v74, v78
    v_mfma_f32_16x16x32_bf16 v[92:95], v[228:231], a[196:199], v[92:95]
    ds_read_b128 a[28:31], v3 offset:224
    v_cvt_pk_bf16_f32 v13, v75, v79
    v_mfma_f32_16x16x32_bf16 v[96:99], v[228:231], a[200:203], v[96:99]
    ds_read_b128 a[32:35], v3 offset:416
    v_cvt_pk_bf16_f32 v2, v80, v84
    v_mfma_f32_16x16x32_bf16 v[100:103], v[228:231], a[204:207], v[100:103]
    ds_read_b128 a[36:39], v3 offset:48
    v_cvt_pk_bf16_f32 v6, v81, v85
    v_mfma_f32_16x16x32_bf16 v[104:107], v[228:231], a[208:211], v[104:107]
    ds_read_b128 a[40:43], v3 offset:240
    v_cvt_pk_bf16_f32 v10, v82, v86
    v_mfma_f32_16x16x32_bf16 v[108:111], v[228:231], a[212:215], v[108:111]
    ds_read_b128 a[44:47], v3 offset:432
    v_cvt_pk_bf16_f32 v14, v83, v87
L_mid:
    s_waitcnt lgkmcnt(9)
    v_mfma_f32_16x16x32_bf16 v[32:35], v[112:115], a[0:3], 0
    ds_read_b128 a[48:51], v3 offset:64
    v_cvt_pk_bf16_f32 v16, v88, v92
    v_smfmac_f32_16x16x64_bf16 v[32:35], v[116:119], a[4:11], v232
    ds_read_b128 a[52:55], v3 offset:256
    v_cvt_pk_bf16_f32 v20, v89, v93
    s_waitcnt lgkmcnt(8)
    v_mfma_f32_16x16x32_bf16 v[36:39], v[120:123], a[12:15], 0
    ds_read_b128 a[56:59], v3 offset:448
    v_cvt_pk_bf16_f32 v24, v90, v94
    v_smfmac_f32_16x16x64_bf16 v[36:39], v[124:127], a[16:23], v232
    ds_read_b128 a[60:63], v3 offset:80
    v_cvt_pk_bf16_f32 v28, v91, v95
    s_waitcnt lgkmcnt(7)
    v_mfma_f32_16x16x32_bf16 v[40:43], v[128:131], a[24:27], 0
    ds_read_b128 a[64:67], v3 offset:272
    v_cvt_pk_bf16_f32 v17, v96, v100
    v_smfmac_f32_16x16x64_bf16 v[40:43], v[132:135], a[28:35], v232
    ds_read_b128 a[68:71], v3 offset:464
    v_cvt_pk_bf16_f32 v208, v32, v33
    s_waitcnt lgkmcnt(6)
    v_mfma_f32_16x16x32_bf16 v[44:47], v[136:139], a[36:39], 0
    ds_read_b128 a[72:75], v3 offset:96
    v_cvt_pk_bf16_f32 v212, v34, v35
    v_smfmac_f32_16x16x64_bf16 v[44:47], v[140:143], a[40:47], v232
    ds_read_b128 a[76:79], v3 offset:288
    v_cvt_pk_bf16_f32 v209, v36, v37
    s_waitcnt lgkmcnt(5)
    v_mfma_f32_16x16x32_bf16 v[48:51], v[144:147], a[48:51], 0
    ds_read_b128 a[80:83], v3 offset:480
    v_cvt_pk_bf16_f32 v213, v38, v39
    v_smfmac_f32_16x16x64_bf16 v[48:51], v[148:151], a[52:59], v232
    ds_read_b128 a[84:87], v3 offset:112
    v_cvt_pk_bf16_f32 v210, v40, v41
    s_waitcnt lgkmcnt(4)
    v_mfma_f32_16x16x32_bf16 v[52:55], v[152:155], a[60:63], 0
    ds_read_b128 a[88:91], v3 offset:304
    v_cvt_pk_bf16_f32 v214, v42, v43
    v_smfmac_f32_16x16x64_bf16 v[52:55], v[156:159], a[64:71], v232
    ds_read_b128 a[92:95], v3 offset:496
    v_cvt_pk_bf16_f32 v211, v44, v45
    s_waitcnt lgkmcnt(3)
    v_mfma_f32_16x16x32_bf16 v[56:59], v[160:163], a[72:75], 0
    ds_read_b128 a[96:99], v3 offset:128
    v_cvt_pk_bf16_f32 v215, v46, v47
L_pad1:
    s_cbranch_execz L_back
    v_mfma_f32_16x16x32_bf16 v[64:67], v[208:211], a[144:147], 0
    ds_read_b128 a[100:103], v3 offset:320
    v_cvt_pk_bf16_f32 v21, v97, v101
    v_smfmac_f32_16x16x64_bf16 v[56:59], v[164:167], a[76:83], v232
    ds_read_b128 a[104:107], v3 offset:512
    v_cvt_pk_bf16_f32 v25, v98, v102
    v_mfma_f32_16x16x32_bf16 v[68:71], v[208:211], a[148:151], 0
    ds_read_b128 a[0:3], v3 offset:144
    v_cvt_pk_bf16_f32 v29, v99, v103
    s_waitcnt lgkmcnt(4)
    v_mfma_f32_16x16x32_bf16 v[60:63], v[168:171], a[84:87], 0
    ds_read_b128 a[4:7], v3 offset:336
    v_cvt_pk_bf16_f32 v18, v104, v108
    v_mfma_f32_16x16x32_bf16 v[72:75], v[208:211], a[152:155], 0
    ds_read_b128 a[8:11], v3 offset:528
    v_cvt_pk_bf16_f32 v22, v105, v109
    v_smfmac_f32_16x16x64_bf16 v[60:63], v[172:175], a[88:95], v232
    ds_read_b128 a[12:15], v3 offset:160
    v_cvt_pk_bf16_f32 v26, v106, v110
    v_mfma_f32_16x16x32_bf16 v[76:79], v[208:211], a[156:159], 0
    ds_read_b128 a[16:19], v3 offset:352
    v_cvt_pk_bf16_f32 v30, v107, v111
    s_waitcnt lgkmcnt(5)
    v_mfma_f32_16x16x32_bf16 v[32:35], v[176:179], a[96:99], 0
    ds_read_b128 a[20:23], v3 offset:544
    v_cvt_pk_bf16_f32 v216, v48, v49
    v_mfma_f32_16x16x32_bf16 v[80:83], v[208:211], a[160:163], 0
    ds_read_b128 a[24:27], v3 offset:176
    v_cvt_pk_bf16_f32 v217, v52, v53
    v_smfmac_f32_16x16x64_bf16 v[32:35], v[180:183], a[100:107], v232
    ds_read_b128 a[28:31], v3 offset:368
    v_cvt_pk_bf16_f32 v218, v56, v57
    v_mfma_f32_16x16x32_bf16 v[84:87], v[208:211], a[164:167], 0
    ds_read_b128 a[32:35], v3 offset:560
    v_cvt_pk_bf16_f32 v219, v60, v61
    s_waitcnt lgkmcnt(6)
    v_mfma_f32_16x16x32_bf16 v[36:39], v[184:187], a[0:3], 0
    v_cvt_pk_bf16_f32 v220, v50, v51
    v_cvt_pk_bf16_f32 v221, v54, v55
    v_mfma_f32_16x16x32_bf16 v[88:91], v[212:215], a[144:147], 0
    v_cvt_pk_bf16_f32 v222, v58, v59
    v_cvt_pk_bf16_f32 v223, v62, v63
    v_smfmac_f32_16x16x64_bf16 v[36:39], v[188:191], a[4:11], v232
    v_cvt_pk_bf16_f32 v224, v32, v33
    v_cvt_pk_bf16_f32 v228, v34, v35
    v_mfma_f32_16x16x32_bf16 v[92:95], v[212:215], a[148:151], 0
    s_cbranch_vccz L_calm
    buffer_store_dwordx3 v[0:2], v7, s[24:27], s34 offen nt
    buffer_store_dwordx3 v[4:6], v7, s[24:27], s36 offen nt
    s_waitcnt lgkmcnt(3)
    v_mfma_f32_16x16x32_bf16 v[40:43], v[192:195], a[12:15], 0
    v_mfma_f32_16x16x32_bf16 v[96:99], v[212:215], a[152:155], 0
    v_smfmac_f32_16x16x64_bf16 v[40:43], v[196:199], a[16:23], v232
    v_cvt_pk_bf16_f32 v225, v36, v37
    v_cvt_pk_bf16_f32 v229, v38, v39
    v_mfma_f32_16x16x32_bf16 v[100:103], v[212:215], a[156:159], 0
    buffer_store_dwordx3 v[8:10], v7, s[24:27], s38 offen nt
    buffer_store_dwordx3 v[12:14], v7, s[24:27], s40 offen nt
    s_waitcnt lgkmcnt(0)
    v_mfma_f32_16x16x32_bf16 v[44:47], v[200:203], a[24:27], 0
    v_mfma_f32_16x16x32_bf16 v[104:107], v[212:215], a[160:163], 0
    v_smfmac_f32_16x16x64_bf16 v[44:47], v[204:207], a[28:35], v232
    v_cvt_pk_bf16_f32 v226, v40, v41
    v_cvt_pk_bf16_f32 v230, v42, v43
    v_mfma_f32_16x16x32_bf16 v[108:111], v[212:215], a[164:167], 0
    buffer_store_dwordx3 v[16:18], v7, s[24:27], s35 offen nt
    buffer_store_dwordx3 v[20:22], v7, s[24:27], s37 offen nt
    v_mfma_f32_16x16x32_bf16 v[64:67], v[216:219], a[168:171], v[64:67]
    v_mfma_f32_16x16x32_bf16 v[68:71], v[216:219], a[172:175], v[68:71]
    v_mfma_f32_16x16x32_bf16 v[72:75], v[216:219], a[176:179], v[72:75]
    v_cvt_pk_bf16_f32 v227, v44, v45
    v_cvt_pk_bf16_f32 v231, v46, v47
    v_mfma_f32_16x16x32_bf16 v[76:79], v[216:219], a[180:183], v[76:79]
    buffer_store_dwordx3 v[24:26], v7, s[24:27], s39 offen nt
    buffer_store_dwordx3 v[28:30], v7, s[24:27], s41 offen nt
    v_mfma_f32_16x16x32_bf16 v[80:83], v[216:219], a[184:187], v[80:83]
    v_mfma_f32_16x16x32_bf16 v[84:87], v[216:219], a[188:191], v[84:87]
    v_mfma_f32_16x16x32_bf16 v[64:67], v[224:227], a[192:195], v[64:67]
    v_mfma_f32_16x16x32_bf16 v[68:71], v[224:227], a[196:199], v[68:71]
    v_mfma_f32_16x16x32_bf16 v[72:75], v[224:227], a[200:203], v[72:75]
    v_mfma_f32_16x16x32_bf16 v[76:79], v[224:227], a[204:207], v[76:79]
    v_add_u32 v7, s42, v15
    s_add_u32 s42, s42, s49
    v_mfma_f32_16x16x32_bf16 v[80:83], v[224:227], a[208:211], v[80:83]
    v_add_u32 v3, s48, v3
    s_sub_u32 s48, 41024, s48
    v_mfma_f32_16x16x32_bf16 v[84:87], v[224:227], a[212:215], v[84:87]
    s_sub_u32 s49, s45, s49
    s_sub_u32 s44, s44, 1
    s_cbranch_scc0 L_loop
    v_mfma_f32_16x16x32_bf16 v[88:91], v[220:223], a[168:171], v[88:91]
    v_cvt_pk_bf16_f32 v0, v64, v68
    v_cvt_pk_bf16_f32 v1, v72, v76
    v_mfma_f32_16x16x32_bf16 v[88:91], v[228:231], a[192:195], v[88:91]
    v_cvt_pk_bf16_f32 v4, v65, v69
    v_cvt_pk_bf16_f32 v5, v73, v77
    v_mfma_f32_16x16x32_bf16 v[92:95], v[220:223], a[172:175], v[92:95]
    v_cvt_pk_bf16_f32 v8, v66, v70
    v_cvt_pk_bf16_f32 v9, v74, v78
    v_mfma_f32_16x16x32_bf16 v[92:95], v[228:231], a[196:199], v[92:95]
    v_cvt_pk_bf16_f32 v12, v67, v71
    v_cvt_pk_bf16_f32 v13, v75, v79
    v_mfma_f32_16x16x32_bf16 v[96:99], v[220:223], a[176:179], v[96:99]
    v_cvt_pk_bf16_f32 v2, v80, v84
    buffer_store_dwordx3 v[0:2], v7, s[24:27], s34 offen nt
    v_mfma_f32_16x16x32_bf16 v[96:99], v[228:231], a[200:203], v[96:99]
    v_cvt_pk_bf16_f32 v6, v81, v85
    buffer_store_dwordx3 v[4:6], v7, s[24:27], s36 offen nt
    v_mfma_f32_16x16x32_bf16 v[100:103], v[220:223], a[180:183], v[100:103]
    v_cvt_pk_bf16_f32 v10, v82, v86
    buffer_store_dwordx3 v[8:10], v7, s[24:27], s38 offen nt
    v_mfma_f32_16x16x32_bf16 v[100:103], v[228:231], a[204:207], v[100:103]
    v_cvt_pk_bf16_f32 v14, v83, v87
    buffer_store_dwordx3 v[12:14], v7, s[24:27], s40 offen nt
    v_mfma_f32_16x16x32_bf16 v[104:107], v[220:223], a[184:187], v[104:107]
    v_cvt_pk_bf16_f32 v16, v88, v92
    v_cvt_pk_bf16_f32 v20, v89, v93
    v_mfma_f32_16x16x32_bf16 v[104:107], v[228:231], a[208:211], v[104:107]
    v_cvt_pk_bf16_f32 v24, v90, v94
    v_cvt_pk_bf16_f32 v28, v91, v95
    v_mfma_f32_16x16x32_bf16 v[108:111], v[220:223], a[188:191], v[108:111]
    v_cvt_pk_bf16_f32 v17, v96, v100
    v_cvt_pk_bf16_f32 v21, v97, v101
    v_mfma_f32_16x16x32_bf16 v[108:111], v[228:231], a[212:215], v[108:111]
    v_cvt_pk_bf16_f32 v25, v98, v102
    v_cvt_pk_bf16_f32 v29, v99, v103
    s_nop 5
    v_cvt_pk_bf16_f32 v18, v104, v108
    buffer_store_dwordx3 v[16:18], v7, s[24:27], s35 offen nt
    v_cvt_pk_bf16_f32 v22, v105, v109
    buffer_store_dwordx3 v[20:22], v7, s[24:27], s37 offen nt
    v_cvt_pk_bf16_f32 v26, v106, v110
    buffer_store_dwordx3 v[24:26], v7, s[24:27], s39 offen nt
    v_cvt_pk_bf16_f32 v30, v107, v111
    buffer_store_dwordx3 v[28:30], v7, s[24:27], s41 offen nt
L_end:
    s_endpgm
L_pad2:
    s_branch L_back
L_calm:
    s_waitcnt lgkmcnt(3)
    v_mfma_f32_16x16x32_bf16 v[40:43], v[192:195], a[12:15], 0
    v_mfma_f32_16x16x32_bf16 v[96:99], v[212:215], a[152:155], 0
    v_smfmac_f32_16x16x64_bf16 v[40:43], v[196:199], a[16:23], v232
    v_cvt_pk_bf16_f32 v225, v36, v37
    v_cvt_pk_bf16_f32 v229, v38, v39
    v_mfma_f32_16x16x32_bf16 v[100:103], v[212:215], a[156:159], 0
    s_waitcnt lgkmcnt(0)
    v_mfma_f32_16x16x32_bf16 v[44:47], v[200:203], a[24:27], 0
    v_mfma_f32_16x16x32_bf16 v[104:107], v[212:215], a[160:163], 0
    v_smfmac_f32_16x16x64_bf16 v[44:47], v[204:207], a[28:35], v232
    s_nop 0
    v_cvt_pk_bf16_f32 v226, v40, v41
    v_cvt_pk_bf16_f32 v230, v42, v43
    v_mfma_f32_16x16x32_bf16 v[108:111], v[212:215], a[164:167], 0
    v_mfma_f32_16x16x32_bf16 v[64:67], v[216:219], a[168:171], v[64:67]
    v_mfma_f32_16x16x32_bf16 v[68:71], v[216:219], a[172:175], v[68:71]
    v_mfma_f32_16x16x32_bf16 v[72:75], v[216:219], a[176:179], v[72:75]
    s_nop 0
    v_cvt_pk_bf16_f32 v227, v44, v45
    v_cvt_pk_bf16_f32 v231, v46, v47
    v_mfma_f32_16x16x32_bf16 v[76:79], v[216:219], a[180:183], v[76:79]
    v_mfma_f32_16x16x32_bf16 v[80:83], v[216:219], a[184:187], v[80:83]
    v_mfma_f32_16x16x32_bf16 v[84:87], v[216:219], a[188:191], v[84:87]
    v_mfma_f32_16x16x32_bf16 v[64:67], v[224:227], a[192:195], v[64:67]
    v_mfma_f32_16x16x32_bf16 v[68:71], v[224:227], a[196:199], v[68:71]
    v_mfma_f32_16x16x32_bf16 v[72:75], v[224:227], a[200:203], v[72:75]
    v_mfma_f32_16x16x32_bf16 v[76:79], v[224:227], a[204:207], v[76:79]
    v_add_u32 v7, s42, v15
    v_mfma_f32_16x16x32_bf16 v[80:83], v[224:227], a[208:211], v[80:83]
    s_add_u32 s42, s42, s33
    v_add_u32 v3, s33, v3
    v_mfma_f32_16x16x32_bf16 v[84:87], v[224:227], a[212:215], v[84:87]
    s_add_u32 s43, s43, 1
    s_cmp_eq_u32 s43, 1
    s_cbranch_scc1 L_loop
    s_cmp_lg_u32 s43, 2
    s_cbranch_scc1 L_enable
    v_accvgpr_write_b32 a216, v0
    v_accvgpr_write_b32 a217, v1
    v_accvgpr_write_b32 a218, v2
    v_accvgpr_write_b32 a220, v4
    v_accvgpr_write_b32 a221, v5
    v_accvgpr_write_b32 a222, v6
    v_accvgpr_write_b32 a224, v8
    v_accvgpr_write_b32 a225, v9
    v_accvgpr_write_b32 a226, v10
    v_accvgpr_write_b32 a228, v12
    v_accvgpr_write_b32 a229, v13
    v_accvgpr_write_b32 a230, v14
    v_accvgpr_write_b32 a232, v16
    v_accvgpr_write_b32 a233, v17
    v_accvgpr_write_b32 a234, v18
    v_accvgpr_write_b32 a236, v20
    v_accvgpr_write_b32 a237, v21
    v_accvgpr_write_b32 a238, v22
    v_accvgpr_write_b32 a240, v24
    v_accvgpr_write_b32 a241, v25
    v_accvgpr_write_b32 a242, v26
    v_accvgpr_write_b32 a244, v28
    v_accvgpr_write_b32 a245, v29
    v_accvgpr_write_b32 a246, v30
    s_branch L_loop
L_enable:
    s_mov_b64 vcc, -1
    s_cmp_eq_u32 s43, 4
    s_cbranch_scc1 L_loop
    v_mov_b32 v3, v19
    s_mov_b32 s42, s45
    s_barrier
    buffer_store_dwordx3 v[0:2], v15, s[24:27], s34 offen offset:1536 nt
    buffer_store_dwordx3 v[4:6], v15, s[24:27], s36 offen offset:1536 nt
    buffer_store_dwordx3 v[8:10], v15, s[24:27], s38 offen offset:1536 nt
    buffer_store_dwordx3 v[12:14], v15, s[24:27], s40 offen offset:1536 nt
    v_mfma_f32_16x16x32_bf16 v[88:91], v[220:223], a[168:171], v[88:91]
    buffer_store_dwordx3 v[16:18], v15, s[24:27], s35 offen offset:1536 nt
    ds_read_b128 a[0:3], v3 offset:0
    v_cvt_pk_bf16_f32 v0, v64, v68
    v_mfma_f32_16x16x32_bf16 v[92:95], v[220:223], a[172:175], v[92:95]
    buffer_store_dwordx3 v[20:22], v15, s[24:27], s37 offen offset:1536 nt
    ds_read_b128 a[4:7], v3 offset:192
    v_cvt_pk_bf16_f32 v4, v65, v69
    v_mfma_f32_16x16x32_bf16 v[96:99], v[220:223], a[176:179], v[96:99]
    buffer_store_dwordx3 v[24:26], v15, s[24:27], s39 offen offset:1536 nt
    ds_read_b128 a[8:11], v3 offset:384
    v_cvt_pk_bf16_f32 v8, v66, v70
    v_mfma_f32_16x16x32_bf16 v[100:103], v[220:223], a[180:183], v[100:103]
    buffer_store_dwordx3 v[28:30], v15, s[24:27], s41 offen offset:1536 nt
    ds_read_b128 a[12:15], v3 offset:16
    v_cvt_pk_bf16_f32 v12, v67, v71
    v_mfma_f32_16x16x32_bf16 v[104:107], v[220:223], a[184:187], v[104:107]
    buffer_store_dwordx3 a[216:218], v15, s[24:27], s34 offen offset:0 nt
    ds_read_b128 a[16:19], v3 offset:208
    v_cvt_pk_bf16_f32 v1, v72, v76
    v_mfma_f32_16x16x32_bf16 v[108:111], v[220:223], a[188:191], v[108:111]
    buffer_store_dwordx3 a[220:222], v15, s[24:27], s36 offen offset:0 nt
    ds_read_b128 a[20:23], v3 offset:400
    v_cvt_pk_bf16_f32 v5, v73, v77
    v_mfma_f32_16x16x32_bf16 v[88:91], v[228:231], a[192:195], v[88:91]
    buffer_store_dwordx3 a[224:226], v15, s[24:27], s38 offen offset:0 nt
    ds_read_b128 a[24:27], v3 offset:32
    v_cvt_pk_bf16_f32 v9, v74, v78
    v_mfma_f32_16x16x32_bf16 v[92:95], v[228:231], a[196:199], v[92:95]
    buffer_store_dwordx3 a[228:230], v15, s[24:27], s40 offen offset:0 nt
    ds_read_b128 a[28:31], v3 offset:224
    v_cvt_pk_bf16_f32 v13, v75, v79
    v_mfma_f32_16x16x32_bf16 v[96:99], v[228:231], a[200:203], v[96:99]
    buffer_store_dwordx3 a[232:234], v15, s[24:27], s35 offen offset:0 nt
    ds_read_b128 a[32:35], v3 offset:416
    v_cvt_pk_bf16_f32 v2, v80, v84
    v_mfma_f32_16x16x32_bf16 v[100:103], v[228:231], a[204:207], v[100:103]
    buffer_store_dwordx3 a[236:238], v15, s[24:27], s37 offen offset:0 nt
    ds_read_b128 a[36:39], v3 offset:48
    v_cvt_pk_bf16_f32 v6, v81, v85
    v_mfma_f32_16x16x32_bf16 v[104:107], v[228:231], a[208:211], v[104:107]
    buffer_store_dwordx3 a[240:242], v15, s[24:27], s39 offen offset:0 nt
    ds_read_b128 a[40:43], v3 offset:240
    v_cvt_pk_bf16_f32 v10, v82, v86
    v_mfma_f32_16x16x32_bf16 v[108:111], v[228:231], a[212:215], v[108:111]
    buffer_store_dwordx3 a[244:246], v15, s[24:27], s41 offen offset:0 nt
    ds_read_b128 a[44:47], v3 offset:432
    v_cvt_pk_bf16_f32 v14, v83, v87
    s_branch L_mid
L_text_end:
.section .rodata,"a"
.p2align 6
.amdhsa_kernel standalone__depthwise_separable__vision_kernel
  .amdhsa_next_free_vgpr 504
  .amdhsa_next_free_sgpr 60
  .amdhsa_accum_offset 256
  .amdhsa_group_segment_fixed_size 0
  .amdhsa_kernarg_size 48
  .amdhsa_user_sgpr_count 2
  .amdhsa_user_sgpr_kernarg_segment_ptr 1
  .amdhsa_system_sgpr_workgroup_id_x 1
  .amdhsa_float_denorm_mode_32 3
.end_amdhsa_kernel
```
